```python
import torch

def _softmax(x, axis=-1):
    return torch.softmax(x, dim=axis)
def _gelu(x):
    return torch.nn.functional.gelu(x, approximate="tanh")
def _silu(x):
    return torch.nn.functional.silu(x)
def _sigmoid(x):
    return torch.sigmoid(x)
def _layernorm(x, axis=-1, eps=1e-5):
    m = x.mean(dim=axis, keepdim=True)
    v = x.var(dim=axis, keepdim=True, unbiased=False)
    return (x - m) / torch.sqrt(v + eps)
def _scatter_add(tgt, idx, src, axis=0):
    return tgt.clone().index_add_(axis, idx, src)
def _segment_sum(src, seg, n):
    out = torch.zeros((n,) + src.shape[1:], dtype=src.dtype)
    return out.index_add_(0, seg, src)
def _pad(x, pw):
    flat = tuple(v for pair in reversed(pw) for v in pair)
    return torch.nn.functional.pad(x, flat)

kernel_name = 'standalone__gqa_block_cached__sampling'

def setup_inputs():

    _w = (lambda a: (lambda t: t.to(torch.bfloat16) if t.is_floating_point() else t)(torch.as_tensor(a)))
    B, Sq, D = 16, 1, 1024
    Hq, Hkv, Sk, Dh = 32, 4, 4096, 128
    assert Hq % Hkv == 0, (Hq, Hkv)
    return {
        "x": _w((lambda *s: torch.randn(*s, dtype=torch.bfloat16) * 0.8)(B, Sq, D)),
        "k_cache": _w((lambda *s: torch.randn(*s, dtype=torch.bfloat16) * 0.8)(B, Hkv, Sk, Dh)),
        "v_cache": _w((lambda *s: torch.randn(*s, dtype=torch.bfloat16) * 0.05)(B, Hkv, Sk, Dh)),
        "wq": _w((lambda *s: torch.randn(*s, dtype=torch.bfloat16) * 0.8)(D, Hq * Dh) * (D ** -0.5)),
        "wo": _w((lambda *s: torch.randn(*s, dtype=torch.bfloat16) * 0.05)(Hq * Dh, D) * ((Hq * Dh) ** -0.5)),
    }

def reference(x, k_cache, v_cache, wq, wo):
    B, Sq, D = x.shape
    Hq, Dh = 32, 128
    Hkv = k_cache.shape[1]
    rep = Hq // Hkv
    q = (lambda x, *d: x.permute(*d))((x @ wq).reshape(B, Sq, Hq, Dh), 0, 2, 1, 3)
    k = (lambda x, n, axis: torch.repeat_interleave(x, n, dim=axis))(k_cache, rep, axis=1)
    v = (lambda x, n, axis: torch.repeat_interleave(x, n, dim=axis))(v_cache, rep, axis=1)
    scores = torch.einsum("bhqd,bhkd->bhqk", q, k) * (Dh ** -0.5)
    p = _softmax(scores, axis=-1)
    o = torch.einsum("bhqk,bhkd->bhqd", p, v)
    return (lambda x, *d: x.permute(*d))(o, 0, 2, 1, 3).reshape(B, Sq, Hq * Dh) @ wo
```

```asm
; @launch grid=(256,1,1) block=(512,1,1) lds=74752
.amdgcn_target "amdgcn-amd-amdhsa--gfx950"
.text
.p2align 12
.rept 832
    s_endpgm
.endr
.globl standalone__gqa_block_cached__sampling_kernel
.p2align 8
.type standalone__gqa_block_cached__sampling_kernel,@function
standalone__gqa_block_cached__sampling_kernel:
    s_load_dwordx16 s[4:19], s[0:1], 0
    v_lshrrev_b32 v4, 6, v0
    v_and_b32 v1, 63, v0
    s_cmp_ge_u32 s2, 256
    s_cbranch_scc1 L_end
    v_readfirstlane_b32 s3, v4
    v_lshrrev_b32 v8, 3, v1
    v_and_b32 v9, 7, v1
    v_lshlrev_b32 v9, 4, v9
    v_lshl_add_u32 v7, v8, 13, v9
    s_bfe_u32 s67, s2, 0x20001
    s_lshr_b32 s68, s2, 3
    s_xor_b32 s66, s68, s2
    s_and_b32 s66, s66, 1
    s_lshl_b32 s66, s66, 5
    s_or_b32 s68, s68, s66
    s_lshl_b32 s66, s67, 3
    s_add_u32 s69, s66, s3
    s_lshl_b32 s66, s69, 11
    s_add_u32 s66, s66, s68
    s_lshl_b32 s66, s66, 7
    s_and_b32 s59, s68, 7
    s_lshl_b32 s73, s3, 12
    s_add_u32 m0, s73, 37120
    s_mov_b32 s30, 0x800000
    s_mov_b32 s31, 0x20000
    v_and_b32 v5, 15, v1
    v_lshrrev_b32 v6, 4, v1
    v_lshlrev_b32 v10, 4, v6
    v_lshl_add_u32 v10, v5, 11, v10
    s_lshl_b32 s69, s69, 6
    s_mov_b32 s42, 0x8000
    s_mov_b32 s43, 0x20000
    s_bfe_u32 s71, s2, 0x20003
    s_lshl_b32 s71, s71, 1
    s_bfe_u32 s72, s2, 0x10005
    s_or_b32 s71, s71, s72
    s_lshl_b32 s71, s71, 2
    s_lshr_b32 s72, s2, 6
    s_or_b32 s71, s71, s72
    s_lshl_b32 s71, s71, 3
    s_and_b32 s72, s2, 7
    s_or_b32 s71, s71, s72
    s_lshl_b32 s71, s71, 7
    s_add_u32 s71, s71, 0x1c0000
    s_bfe_u32 s72, s2, 0x20004
    s_lshl_b32 s72, s72, 21
    s_cmp_ge_u32 s2, 192
    s_cselect_b32 s72, s72, 0
    s_add_u32 s71, s71, s72
    s_cmp_eq_u32 s3, 0
    s_waitcnt lgkmcnt(0)
    s_cbranch_scc0 L_nop0
    s_cmp_ge_u32 s2, 192
    s_cselect_b64 s[20:21], s[12:13], s[18:19]
    s_memtime s[52:53]
    s_load_dword s56, s[20:21], s71 glc
L_nop0:
    s_mov_b64 s[28:29], s[10:11]
    buffer_load_dwordx4 v7, s[28:31], s66 offen nt lds
    s_add_u32 m0, m0, 1024
    s_add_u32 s66, s66, 0x10000
    buffer_load_dwordx4 v7, s[28:31], s66 offen nt lds
    s_add_u32 m0, m0, 1024
    s_add_u32 s66, s66, 0x10000
    buffer_load_dwordx4 v7, s[28:31], s66 offen nt lds
    s_add_u32 m0, m0, 1024
    s_add_u32 s66, s66, 0x10000
    buffer_load_dwordx4 v7, s[28:31], s66 offen nt lds
    s_mov_b64 s[40:41], s[4:5]
    s_cmp_eq_u32 s3, 0
    buffer_load_dwordx4 v[176:179], v10, s[40:43], s69 offen
    s_cbranch_scc0 L_nop1
    s_waitcnt lgkmcnt(0)
    s_memtime s[54:55]
L_nop1:
    v_mov_b32 v253, 0x9080
    s_cmp_eq_u32 s3, 0
    s_cbranch_scc0 L_noprobe
    s_bfe_u32 s70, s2, 0x10003
    s_getreg_b32 s57, hwreg(HW_REG_XCC_ID, 0, 3)
    s_lshr_b32 s72, s57, 2
    s_xor_b32 s70, s70, s72
    s_lshl_b32 s57, s57, 29
    s_cmp_eq_u32 s2, 0
    s_cselect_b32 s57, s57, 0
    s_waitcnt lgkmcnt(0)
    s_sub_u32 s54, s54, s52
    s_min_u32 s54, s54, 4000
    s_sub_u32 s55, 4000, s54
    s_cmp_eq_u32 s70, 0
    s_cselect_b32 s54, s54, s55
    s_lshr_b32 s55, s54, 3
    s_lshl_b32 s55, s55, 14
    s_cmp_ge_u32 s2, 192
    s_cselect_b32 s54, s55, s54
    s_add_u32 s54, s54, 0x800000
    s_add_u32 s54, s54, s57
    v_mov_b32 v250, s54
    ds_write_b32 v253, v250 offset:12
L_noprobe:
    s_bitcmp1_b32 s2, 0
    s_cselect_b32 s52, 0x2000000, 0
    s_bitcmp1_b32 s2, 1
    s_cselect_b32 s72, 0x400000, 0
    s_xor_b32 s52, s52, s72
    s_bitcmp1_b32 s2, 2
    s_cselect_b32 s72, 0x800000, 0
    s_xor_b32 s52, s52, s72
    s_bitcmp1_b32 s2, 3
    s_cselect_b32 s72, 0x1e9000, 0
    s_xor_b32 s52, s52, s72
    s_bitcmp1_b32 s2, 4
    s_cselect_b32 s72, 0x74800, 0
    s_xor_b32 s52, s52, s72
    s_bitcmp1_b32 s2, 5
    s_cselect_b32 s72, 0x1000000, 0
    s_xor_b32 s52, s52, s72
    s_bitcmp1_b32 s2, 6
    s_cselect_b32 s72, 0x200000, 0
    s_xor_b32 s52, s52, s72
    s_bitcmp1_b32 s2, 7
    s_cselect_b32 s72, 0x79800, 0
    s_xor_b32 s52, s52, s72
    s_bitcmp1_b32 s3, 0
    s_cselect_b32 s72, 0x42000, 0
    s_xor_b32 s52, s52, s72
    s_bitcmp1_b32 s3, 1
    s_cselect_b32 s72, 0x45000, 0
    s_xor_b32 s52, s52, s72
    s_bitcmp1_b32 s3, 2
    s_cselect_b32 s72, 0x55000, 0
    s_xor_b32 s52, s52, s72
    s_bfe_u32 s63, s2, 0x10004
    s_bfe_u32 s72, s2, 0x10007
    s_lshl_b32 s72, s72, 1
    s_or_b32 s63, s63, s72
    s_lshr_b32 s62, s52, 20
    v_bfe_u32 v11, v5, 1, 1
    v_lshlrev_b32 v11, 2, v11
    v_lshrrev_b32 v12, 2, v5
    v_add_u32 v11, v11, v12
    v_lshlrev_b32 v2, 8, v11
    v_and_b32 v11, 1, v5
    v_lshl_add_u32 v11, v6, 1, v11
    v_lshl_add_u32 v2, v11, 4, v2
    v_lshlrev_b32 v3, 4, v1
    s_mov_b64 s[20:21], s[6:7]
    s_mov_b32 s22, 0x4000000
    s_mov_b32 s23, 0x20000
    s_waitcnt vmcnt(3)
    buffer_load_dwordx4 v[16:19], v2, s[20:23], s52 offen offset:0 nt
    s_mov_b64 s[36:37], s[18:19]
    s_mov_b32 s38, 0x10000000
    s_mov_b32 s39, 0x20000
    s_and_b32 s64, s2, 31
    s_lshr_b32 s65, s2, 5
    s_and_b32 s74, s3, 1
    s_lshl_b32 s74, s74, 14
    s_lshr_b32 s72, s3, 1
    s_lshl_b32 s72, s72, 12
    s_or_b32 s74, s74, s72
    s_and_b32 s72, s62, 3
    s_lshl_b32 s72, s72, 17
    s_or_b32 s74, s74, s72
    s_bfe_u32 s72, s62, 0x20002
    s_lshl_b32 s72, s72, 10
    s_or_b32 s74, s74, s72
    s_lshr_b32 s72, s62, 4
    s_lshl_b32 s72, s72, 15
    s_or_b32 s74, s74, s72
    s_xor_b32 s74, s74, 0x101000
    s_xor_b32 s72, s63, s3
    s_and_b32 s72, s72, 3
    s_lshl_b32 s72, s72, 8
    s_add_u32 s74, s74, s72
    v_lshlrev_b32 v12, 2, v1
    s_lshl_b32 s75, s65, 2
    s_and_b32 s72, s3, 3
    s_or_b32 s75, s75, s72
    s_lshl_b32 s75, s75, 3
    s_lshr_b32 s72, s3, 2
    s_or_b32 s75, s75, s72
    s_lshl_b32 s75, s75, 12
    s_lshl_b32 s72, s3, 2
    s_xor_b32 s72, s72, s64
    v_xor_b32 v13, s72, v6
    v_lshlrev_b32 v13, 7, v13
    s_lshr_b32 s72, s65, 1
    s_and_b32 s72, s72, 2
    v_xor_b32 v11, s72, v6
    v_lshl_add_u32 v13, v11, 13, v13
    v_lshl_add_u32 v13, v5, 3, v13
    v_mov_b32 v248, -1
    v_mov_b32 v249, -1
    v_mov_b32 v250, 0
    v_mov_b32 v251, 0
    v_mov_b32 v252, 1
    ds_write_b64 v253, v[250:251]
    ds_write_b32 v253, v250 offset:8
    s_lshl_b32 s77, s62, 9
    s_add_u32 s77, s77, 0x200000
    s_lshl_b32 s72, s63, 7
    s_add_u32 s76, s77, s72
    v_lshlrev_b32 v14, 3, v1
    v_lshrrev_b32 v8, 2, v5
    v_lshl_add_u32 v8, v6, 3, v8
    v_lshlrev_b32 v8, 7, v8
    v_and_b32 v11, 3, v5
    v_lshl_add_u32 v8, v11, 3, v8
    v_add_u32 v8, s73, v8
    s_mul_i32 s72, s3, 4352
    v_mul_u32_u24 v9, 272, v5
    v_lshl_add_u32 v9, v6, 4, v9
    v_add_u32 v9, s72, v9
    s_mul_i32 s72, s3, 544
    v_lshrrev_b32 v11, 5, v1
    v_mul_u32_u24 v10, 272, v11
    v_and_b32 v15, 31, v1
    v_lshl_add_u32 v10, v15, 3, v10
    v_add_u32 v10, s72, v10
    v_lshlrev_b32 v15, 2, v15
    v_lshl_add_u32 v15, v11, 15, v15
    s_lshl_b32 s78, s3, 16
    s_bfe_u32 s72, s68, 0x30001
    s_lshl_b32 s72, s72, 12
    s_add_u32 s78, s78, s72
    s_lshr_b32 s72, s68, 4
    s_lshl_b32 s72, s72, 10
    s_add_u32 s78, s78, s72
    s_xor_b32 s72, s67, s3
    s_and_b32 s72, s72, 3
    s_lshl_b32 s72, s72, 8
    s_add_u32 s78, s78, s72
    s_and_b32 s72, s68, 1
    s_lshl_b32 s72, s72, 7
    s_add_u32 s78, s78, s72
    s_add_u32 s78, s78, 0x180000
    s_waitcnt vmcnt(3)
    buffer_load_dwordx4 v[20:23], v2, s[20:23], s52 offen offset:128 nt
    s_xor_b32 s52, s52, 0x4a000
    s_waitcnt vmcnt(3)
    buffer_load_dwordx4 v[24:27], v2, s[20:23], s52 offen offset:0 nt
    s_waitcnt vmcnt(3)
    buffer_load_dwordx4 v[28:31], v2, s[20:23], s52 offen offset:128 nt
    ds_read_b64_tr_b16 v[180:181], v8 offset:37120
    ds_read_b64_tr_b16 v[182:183], v8 offset:37632
    ds_read_b64_tr_b16 v[184:185], v8 offset:37152
    ds_read_b64_tr_b16 v[186:187], v8 offset:37664
    ds_read_b64_tr_b16 v[188:189], v8 offset:37184
    ds_read_b64_tr_b16 v[190:191], v8 offset:37696
    ds_read_b64_tr_b16 v[192:193], v8 offset:37216
    ds_read_b64_tr_b16 v[194:195], v8 offset:37728
    s_waitcnt lgkmcnt(6)
    v_mfma_f32_16x16x32_bf16 v[208:211], v[180:183], v[176:179], 0
    s_waitcnt lgkmcnt(4)
    v_mfma_f32_16x16x32_bf16 v[212:215], v[184:187], v[176:179], 0
    s_waitcnt lgkmcnt(2)
    v_mfma_f32_16x16x32_bf16 v[216:219], v[188:191], v[176:179], 0
    s_waitcnt lgkmcnt(0)
    v_mfma_f32_16x16x32_bf16 v[220:223], v[192:195], v[176:179], 0
    s_mov_b64 s[24:25], s[8:9]
    s_mov_b32 s26, 0x4000000
    s_mov_b32 s27, 0x20000
    s_mov_b64 s[32:33], s[12:13]
    s_mov_b32 s34, 0x800000
    s_mov_b32 s35, 0x20000
    s_mov_b64 s[44:45], s[14:15]
    s_mov_b32 s46, 0x8000
    s_mov_b32 s47, 0x20000
    ds_write_b128 v9, v[208:211] offset:0
    ds_write_b128 v9, v[212:215] offset:64
    ds_write_b128 v9, v[216:219] offset:128
    ds_write_b128 v9, v[220:223] offset:192
    s_mov_b64 s[48:49], s[16:17]
    s_mov_b32 s50, 0x100
    s_mov_b32 s51, 0x20000
    s_mov_b32 s60, 0x05040100
    s_mov_b32 s61, 0x07060302
    s_waitcnt lgkmcnt(0)
    s_barrier
    buffer_store_dword v248, v12, s[36:39], s74 offen sc1
    buffer_store_dwordx2 v[248:249], v13, s[36:39], s75 offen sc1
    ds_read_b64 v[224:225], v10 offset:0
    ds_read_b64 v[226:227], v10 offset:4352
    ds_read_b64 v[228:229], v10 offset:8704
    ds_read_b64 v[230:231], v10 offset:13056
    ds_read_b64 v[232:233], v10 offset:17408
    ds_read_b64 v[234:235], v10 offset:21760
    ds_read_b64 v[236:237], v10 offset:26112
    ds_read_b64 v[238:239], v10 offset:30464
    s_waitcnt lgkmcnt(4)
    v_pk_add_f32 v[224:225], v[224:225], v[226:227]
    v_pk_add_f32 v[228:229], v[228:229], v[230:231]
    v_pk_add_f32 v[224:225], v[224:225], v[228:229]
    s_waitcnt lgkmcnt(2)
    v_pk_add_f32 v[232:233], v[232:233], v[234:235]
    v_pk_add_f32 v[224:225], v[224:225], v[232:233]
    s_waitcnt lgkmcnt(0)
    v_pk_add_f32 v[236:237], v[236:237], v[238:239]
    v_pk_add_f32 v[224:225], v[224:225], v[236:237]
    v_cvt_pk_bf16_f32 v224, v224, v225
    s_cmp_lg_u32 s3, 0
    s_cbranch_scc1 L_noclr3
    s_mov_b64 exec, 0xffff
    buffer_store_dwordx2 v[248:249], v14, s[36:39], s76 offen sc1
    s_mov_b64 exec, -1
L_noclr3:
    buffer_store_dword v224, v15, s[36:39], s78 offen sc1
    s_xor_b32 s52, s52, 0xbc000
    s_waitcnt vmcnt(6)
    buffer_load_dwordx4 v[32:35], v2, s[20:23], s52 offen offset:0 nt
    s_waitcnt vmcnt(6)
    buffer_load_dwordx4 v[36:39], v2, s[20:23], s52 offen offset:128 nt
    s_xor_b32 s52, s52, 0x4a000
    s_waitcnt vmcnt(6)
    buffer_load_dwordx4 v[40:43], v2, s[20:23], s52 offen offset:0 nt
    s_waitcnt vmcnt(6)
    buffer_load_dwordx4 v[44:47], v2, s[20:23], s52 offen offset:128 nt
    s_waitcnt vmcnt(4)
    s_mov_b64 exec, 1
    ds_add_rtn_u32 v254, v253, v252
    ds_read_b32 v255, v253 offset:12
    s_and_b32 s79, s2, 63
    s_lshl_b32 s79, s79, 2
    s_waitcnt lgkmcnt(0)
    v_readfirstlane_b32 s72, v254
    v_readfirstlane_b32 s68, v255
    s_mov_b64 exec, -1
    s_cmp_lg_u32 s72, 7
    s_cbranch_scc1 L_noarr
    s_nop 1
    s_atomic_add s68, s[16:17], s79 glc
L_noarr:
    s_cmp_lg_u32 s59, 3
    s_cselect_b32 s67, 1, 0
    s_xor_b32 s52, s52, 0xb8000
    s_waitcnt vmcnt(3)
    s_bitcmp1_b32 s67, 0
    s_cbranch_scc0 L_dd1
    s_waitcnt vmcnt(2)
L_dd1:
    buffer_load_dwordx4 v[48:51], v2, s[20:23], s52 offen offset:0 nt
    s_waitcnt vmcnt(3)
    s_bitcmp1_b32 s67, 0
    s_cbranch_scc0 L_dd2
    s_waitcnt vmcnt(2)
L_dd2:
    buffer_load_dwordx4 v[52:55], v2, s[20:23], s52 offen offset:128 nt
    s_xor_b32 s52, s52, 0x4a000
    s_waitcnt vmcnt(3)
    s_bitcmp1_b32 s67, 0
    s_cbranch_scc0 L_dd3
    s_waitcnt vmcnt(2)
L_dd3:
    buffer_load_dwordx4 v[56:59], v2, s[20:23], s52 offen offset:0 nt
    s_waitcnt vmcnt(3)
    s_bitcmp1_b32 s67, 0
    s_cbranch_scc0 L_dd4
    s_waitcnt vmcnt(2)
L_dd4:
    buffer_load_dwordx4 v[60:63], v2, s[20:23], s52 offen offset:128 nt
    s_barrier
    s_xor_b32 s52, s52, 0xbc000
    s_waitcnt vmcnt(3)
    s_bitcmp1_b32 s67, 0
    s_cbranch_scc0 L_dd5
    s_waitcnt vmcnt(2)
L_dd5:
    buffer_load_dwordx4 v[64:67], v2, s[20:23], s52 offen offset:0 nt
    s_barrier
    s_waitcnt vmcnt(3)
    s_bitcmp1_b32 s67, 0
    s_cbranch_scc0 L_dd6
    s_waitcnt vmcnt(2)
L_dd6:
    buffer_load_dwordx4 v[68:71], v2, s[20:23], s52 offen offset:128 nt
    s_barrier
    s_xor_b32 s52, s52, 0x4a000
    s_waitcnt vmcnt(3)
    s_bitcmp1_b32 s67, 0
    s_cbranch_scc0 L_dd7
    s_waitcnt vmcnt(2)
L_dd7:
    buffer_load_dwordx4 v[72:75], v2, s[20:23], s52 offen offset:0 nt
    s_barrier
    s_waitcnt vmcnt(3)
    s_bitcmp1_b32 s67, 0
    s_cbranch_scc0 L_dd8
    s_waitcnt vmcnt(2)
L_dd8:
    buffer_load_dwordx4 v[76:79], v2, s[20:23], s52 offen offset:128 nt
    s_barrier
    s_xor_b32 s52, s52, 0xe4800
    s_waitcnt vmcnt(3)
    s_bitcmp1_b32 s67, 0
    s_cbranch_scc0 L_dd9
    s_waitcnt vmcnt(2)
L_dd9:
    buffer_load_dwordx4 v[80:83], v2, s[20:23], s52 offen offset:0 nt
    s_barrier
    s_waitcnt vmcnt(3)
    s_bitcmp1_b32 s67, 0
    s_cbranch_scc0 L_dd10
    s_waitcnt vmcnt(2)
L_dd10:
    buffer_load_dwordx4 v[84:87], v2, s[20:23], s52 offen offset:128 nt
    s_barrier
    s_xor_b32 s52, s52, 0x4a000
    s_waitcnt vmcnt(3)
    s_bitcmp1_b32 s67, 0
    s_cbranch_scc0 L_dd11
    s_waitcnt vmcnt(2)
L_dd11:
    buffer_load_dwordx4 v[88:91], v2, s[20:23], s52 offen offset:0 nt
    s_barrier
    s_waitcnt vmcnt(3)
    s_bitcmp1_b32 s67, 0
    s_cbranch_scc0 L_dd12
    s_waitcnt vmcnt(2)
L_dd12:
    buffer_load_dwordx4 v[92:95], v2, s[20:23], s52 offen offset:128 nt
    s_barrier
    s_getreg_b32 s72, hwreg(HW_REG_XCC_ID)
    s_andn2_b32 s67, s67, s72
    s_xor_b32 s52, s52, 0xbc000
    s_waitcnt vmcnt(3)
    s_bitcmp1_b32 s67, 0
    s_cbranch_scc0 L_dd13
    s_waitcnt vmcnt(2)
L_dd13:
    buffer_load_dwordx4 v[96:99], v2, s[20:23], s52 offen offset:0 nt
    s_barrier
    s_waitcnt vmcnt(3)
    s_bitcmp1_b32 s67, 0
    s_cbranch_scc0 L_dd14
    s_waitcnt vmcnt(2)
L_dd14:
    buffer_load_dwordx4 v[100:103], v2, s[20:23], s52 offen offset:128 nt
    s_barrier
    s_xor_b32 s52, s52, 0x4a000
    s_waitcnt vmcnt(3)
    s_bitcmp1_b32 s67, 0
    s_cbranch_scc0 L_dd15
    s_waitcnt vmcnt(2)
L_dd15:
    buffer_load_dwordx4 v[104:107], v2, s[20:23], s52 offen offset:0 nt
    s_barrier
    s_waitcnt vmcnt(3)
    s_bitcmp1_b32 s67, 0
    s_cbranch_scc0 L_dd16
    s_waitcnt vmcnt(2)
L_dd16:
    buffer_load_dwordx4 v[108:111], v2, s[20:23], s52 offen offset:128 nt
    s_barrier
    buffer_load_dword v254, v12, s[48:51], 0 offen sc1
    s_xor_b32 s52, s52, 0xb8000
    s_waitcnt vmcnt(4)
    s_bitcmp1_b32 s67, 0
    s_cbranch_scc0 L_dd17
    s_waitcnt vmcnt(3)
L_dd17:
    buffer_load_dwordx4 v[112:115], v2, s[20:23], s52 offen offset:0 nt
    s_barrier
    s_waitcnt vmcnt(4)
    s_bitcmp1_b32 s67, 0
    s_cbranch_scc0 L_dd18
    s_waitcnt vmcnt(3)
L_dd18:
    buffer_load_dwordx4 v[116:119], v2, s[20:23], s52 offen offset:128 nt
    s_barrier
    s_xor_b32 s52, s52, 0x4a000
    s_waitcnt vmcnt(4)
    s_bitcmp1_b32 s67, 0
    s_cbranch_scc0 L_dd19
    s_waitcnt vmcnt(3)
L_dd19:
    buffer_load_dwordx4 v[120:123], v2, s[20:23], s52 offen offset:0 nt
    s_barrier
    s_waitcnt vmcnt(4)
    s_bitcmp1_b32 s67, 0
    s_cbranch_scc0 L_dd20
    s_waitcnt vmcnt(3)
L_dd20:
    buffer_load_dwordx4 v[124:127], v2, s[20:23], s52 offen offset:128 nt
    s_barrier
    s_waitcnt vmcnt(4)
    s_mov_b32 s72, 0
L_poll0:
    v_bfe_u32 v255, v254, 23, 6
    v_cmp_gt_u32 vcc, 4, v255
    s_cbranch_vccz L_poll0_done
    s_add_u32 s72, s72, 1
    s_cmp_gt_u32 s72, 400000
    s_cbranch_scc1 L_poll0_done
    s_sleep 8
    buffer_load_dword v254, v12, s[48:51], 0 offen sc1
    s_waitcnt vmcnt(0)
    s_branch L_poll0
L_poll0_done:
    s_lshr_b32 s79, s62, 2
    s_lshl_b32 s79, s79, 3
    s_add_u32 s79, s79, s3
    s_lshl_b32 s79, s79, 2
    s_and_b32 s72, s62, 3
    s_add_u32 s79, s79, s72
    s_lshl_b32 s79, s79, 10
    s_add_u32 s79, s79, 0x180000
    buffer_load_dwordx4 v[176:179], v3, s[36:39], s79 offen sc1
    v_bfe_u32 v255, v254, 14, 9
    v_readfirstlane_b32 s71, v254
    v_and_b32 v254, 0x3fff, v254
    v_lshrrev_b32 v249, 1, v1
    s_lshr_b32 s71, s71, 29
    v_add_u32_dpp v248, v254, v254 row_ror:8 row_mask:0xf bank_mask:0xf
    v_add_u32 v250, s71, v1
    v_cmp_lt_u32 vcc, 12000, v248
    v_xor_b32 v249, v249, v250
    v_and_b32 v249, 4, v249
    v_cmp_ne_u32 s[4:5], 0, v249
    s_bcnt1_i32_b64 s72, vcc
    s_cmp_gt_u32 s72, 32
    s_cselect_b64 s[6:7], -1, 0
    s_cselect_b32 s70, 4, 0
    v_and_b32 v249, 1, v250
    v_cmp_ne_u32 s[8:9], 0, v249
    v_and_b32 v249, 2, v250
    v_cmp_ne_u32 s[10:11], 0, v249
    v_mov_b32 v248, v254
    v_mov_b32 v249, v254
    v_mov_b32 v250, v254
    s_xor_b64 s[12:13], s[4:5], s[6:7]
    v_permlane16_swap_b32 v248, v249
    v_permlane32_swap_b32 v254, v250
    s_or_b64 s[8:9], s[8:9], s[12:13]
    s_xor_b64 s[8:9], s[8:9], s[4:5]
    s_xor_b64 s[10:11], s[10:11], s[6:7]
    v_cmp_gt_u32 vcc, v248, v249
    v_cmp_gt_u32 s[4:5], v254, v250
    s_nop 3
    s_xor_b64 s[8:9], s[8:9], vcc
    s_xor_b64 s[10:11], s[10:11], s[4:5]
    s_bcnt0_i32_b64 s72, s[8:9]
    s_cmp_gt_u32 s72, 32
    s_addc_u32 s70, s70, 0
    s_bcnt0_i32_b64 s72, s[10:11]
    s_cmp_gt_u32 s72, 32
    s_cselect_b32 s72, 2, 0
    s_or_b32 s70, s70, s72
    s_add_u32 s72, s71, s64
    s_and_b32 s72, s72, 7
    s_xor_b32 s72, s72, s70
    s_and_b32 s64, s64, 24
    s_or_b32 s64, s64, s72
    v_add_u32_dpp v255, v255, v255 row_ror:8 row_mask:0xf bank_mask:0xf
    s_mov_b32 s58, 0
    v_cmp_lt_u32 vcc, 499, v255
    s_nop 3
    s_xor_b64 s[4:5], vcc, s[6:7]
    s_lshr_b32 s72, s5, 16
    s_bcnt1_i32_b32 s72, s72
    s_cmp_gt_u32 s72, 8
    s_addc_u32 s58, s58, s58
    s_and_b32 s72, s5, 0xffff
    s_bcnt1_i32_b32 s72, s72
    s_cmp_gt_u32 s72, 8
    s_addc_u32 s58, s58, s58
    s_lshr_b32 s72, s4, 16
    s_bcnt1_i32_b32 s72, s72
    s_cmp_gt_u32 s72, 8
    s_addc_u32 s58, s58, s58
    s_and_b32 s72, s4, 0xffff
    s_bcnt1_i32_b32 s72, s72
    s_cmp_gt_u32 s72, 8
    s_addc_u32 s58, s58, s58
    v_and_b32 v250, 1, v5
    v_lshlrev_b32 v250, 4, v250
    v_mov_b32 v251, 0x3f80
    v_lshlrev_b32 v250, v250, v251
    v_lshrrev_b32 v249, 2, v5
    v_and_b32 v248, 2, v5
    v_lshl_add_u32 v249, v248, 1, v249
    v_lshlrev_b32 v249, v249, v252
    v_bfe_i32 v180, v249, 0, 1
    v_and_b32 v180, v180, v250
    v_bfe_i32 v181, v249, 1, 1
    v_and_b32 v181, v181, v250
    v_bfe_i32 v182, v249, 2, 1
    v_and_b32 v182, v182, v250
    v_bfe_i32 v183, v249, 3, 1
    v_and_b32 v183, v183, v250
    s_mul_i32 s72, s3, 272
    v_lshlrev_b32 v11, 2, v6
    v_lshl_add_u32 v11, v5, 4, v11
    v_add_u32 v11, s72, v11
    s_xor_b32 s52, s52, 0xbc000
    s_waitcnt vmcnt(4)
    s_bitcmp1_b32 s67, 0
    s_cbranch_scc0 L_dd21
    s_waitcnt vmcnt(3)
L_dd21:
    buffer_load_dwordx4 v[128:131], v2, s[20:23], s52 offen offset:0 nt
    s_barrier
    s_waitcnt vmcnt(4)
    s_bitcmp1_b32 s67, 0
    s_cbranch_scc0 L_dd22
    s_waitcnt vmcnt(3)
L_dd22:
    buffer_load_dwordx4 v[132:135], v2, s[20:23], s52 offen offset:128 nt
    s_barrier
    s_xor_b32 s52, s52, 0x4a000
    s_waitcnt vmcnt(4)
    s_bitcmp1_b32 s67, 0
    s_cbranch_scc0 L_dd23
    s_waitcnt vmcnt(3)
L_dd23:
    buffer_load_dwordx4 v[136:139], v2, s[20:23], s52 offen offset:0 nt
    s_barrier
    s_waitcnt vmcnt(4)
    s_bitcmp1_b32 s67, 0
    s_cbranch_scc0 L_dd24
    s_waitcnt vmcnt(3)
L_dd24:
    buffer_load_dwordx4 v[140:143], v2, s[20:23], s52 offen offset:128 nt
    s_barrier
    s_waitcnt vmcnt(4)
    v_mfma_f32_16x16x32_bf16 v[208:211], v[180:183], v[176:179], 0
    v_and_b32 v10, 7, v5
    v_mul_u32_u24 v10, 272, v10
    v_lshrrev_b32 v4, 3, v5
    v_lshl_add_u32 v4, v6, 1, v4
    v_lshl_add_u32 v10, v4, 4, v10
    s_nop 2
    v_cvt_pk_bf16_f32 v176, v208, v209
    ds_write_b32 v11, v176 offset:34816
    s_mov_b64 exec, 1
    ds_add_u32 v253, v252 offset:4
    s_mov_b64 exec, -1
    s_getreg_b32 s67, hwreg(HW_REG_XCC_ID)
    s_not_b32 s67, s67
    s_xor_b32 s52, s52, 0xe4800
    s_waitcnt vmcnt(3)
    s_bitcmp1_b32 s67, 0
    s_cbranch_scc0 L_dd25
    s_waitcnt vmcnt(2)
L_dd25:
    buffer_load_dwordx4 v[144:147], v3, s[24:27], s52 offen offset:0 nt
    s_barrier
    s_waitcnt vmcnt(3)
    s_bitcmp1_b32 s67, 0
    s_cbranch_scc0 L_dd26
    s_waitcnt vmcnt(2)
L_dd26:
    buffer_load_dwordx4 v[148:151], v3, s[24:27], s52 offen offset:1024 nt
    s_barrier
    s_xor_b32 s52, s52, 0x4a000
    s_waitcnt vmcnt(3)
    s_bitcmp1_b32 s67, 0
    s_cbranch_scc0 L_dd27
    s_waitcnt vmcnt(2)
L_dd27:
    buffer_load_dwordx4 v[152:155], v3, s[24:27], s52 offen offset:0 nt
    s_barrier
    s_waitcnt vmcnt(3)
    s_bitcmp1_b32 s67, 0
    s_cbranch_scc0 L_dd28
    s_waitcnt vmcnt(2)
L_dd28:
    buffer_load_dwordx4 v[156:159], v3, s[24:27], s52 offen offset:1024 nt
    s_barrier
L_qwait:
    ds_read_b32 v254, v253 offset:4
    ds_read_b128 v[240:243], v10 offset:34816
    ds_read_b128 v[244:247], v10 offset:34944
    s_waitcnt lgkmcnt(0)
    v_cmp_ne_u32 vcc, 8, v254
    s_cbranch_vccnz L_qwait
    v_mfma_f32_16x16x32_bf16 v[208:211], v[16:19], v[240:243], 0
    v_mfma_f32_16x16x32_bf16 v[212:215], v[24:27], v[240:243], 0
    v_mfma_f32_16x16x32_bf16 v[216:219], v[32:35], v[240:243], 0
    v_mfma_f32_16x16x32_bf16 v[220:223], v[40:43], v[240:243], 0
    v_mfma_f32_16x16x32_bf16 v[208:211], v[20:23], v[244:247], v[208:211]
    v_mfma_f32_16x16x32_bf16 v[212:215], v[28:31], v[244:247], v[212:215]
    v_mfma_f32_16x16x32_bf16 v[216:219], v[36:39], v[244:247], v[216:219]
    v_mfma_f32_16x16x32_bf16 v[220:223], v[44:47], v[244:247], v[220:223]
    s_xor_b32 s52, s52, 0xbc000
    s_waitcnt vmcnt(3)
    s_bitcmp1_b32 s67, 0
    s_cbranch_scc0 L_dd29
    s_waitcnt vmcnt(2)
L_dd29:
    buffer_load_dwordx4 v[160:163], v3, s[24:27], s52 offen offset:0 nt
    s_barrier
    v_mfma_f32_16x16x32_bf16 v[224:227], v[48:51], v[240:243], 0
    v_mfma_f32_16x16x32_bf16 v[228:231], v[56:59], v[240:243], 0
    v_mfma_f32_16x16x32_bf16 v[232:235], v[64:67], v[240:243], 0
    v_mfma_f32_16x16x32_bf16 v[236:239], v[72:75], v[240:243], 0
    v_mfma_f32_16x16x32_bf16 v[224:227], v[52:55], v[244:247], v[224:227]
    v_mfma_f32_16x16x32_bf16 v[228:231], v[60:63], v[244:247], v[228:231]
    v_mfma_f32_16x16x32_bf16 v[232:235], v[68:71], v[244:247], v[232:235]
    v_mfma_f32_16x16x32_bf16 v[236:239], v[76:79], v[244:247], v[236:239]
    v_add_f32_dpp v176, v209, v208 row_ror:8 row_mask:0xf bank_mask:0xf
    v_add_f32_dpp v177, v211, v210 row_ror:8 row_mask:0xf bank_mask:0xf
    v_add_f32_dpp v178, v213, v212 row_ror:8 row_mask:0xf bank_mask:0xf
    v_add_f32_dpp v179, v215, v214 row_ror:8 row_mask:0xf bank_mask:0xf
    v_add_f32_dpp v180, v217, v216 row_ror:8 row_mask:0xf bank_mask:0xf
    v_add_f32_dpp v181, v219, v218 row_ror:8 row_mask:0xf bank_mask:0xf
    v_add_f32_dpp v182, v221, v220 row_ror:8 row_mask:0xf bank_mask:0xf
    v_add_f32_dpp v183, v223, v222 row_ror:8 row_mask:0xf bank_mask:0xf
    v_mfma_f32_16x16x32_bf16 v[208:211], v[80:83], v[240:243], 0
    v_mfma_f32_16x16x32_bf16 v[212:215], v[88:91], v[240:243], 0
    v_mfma_f32_16x16x32_bf16 v[216:219], v[96:99], v[240:243], 0
    v_mfma_f32_16x16x32_bf16 v[220:223], v[104:107], v[240:243], 0
    v_mfma_f32_16x16x32_bf16 v[208:211], v[84:87], v[244:247], v[208:211]
    v_mfma_f32_16x16x32_bf16 v[212:215], v[92:95], v[244:247], v[212:215]
    v_mfma_f32_16x16x32_bf16 v[216:219], v[100:103], v[244:247], v[216:219]
    v_mfma_f32_16x16x32_bf16 v[220:223], v[108:111], v[244:247], v[220:223]
    v_add_f32_dpp v184, v225, v224 row_ror:8 row_mask:0xf bank_mask:0xf
    v_add_f32_dpp v185, v227, v226 row_ror:8 row_mask:0xf bank_mask:0xf
    v_add_f32_dpp v186, v229, v228 row_ror:8 row_mask:0xf bank_mask:0xf
    v_add_f32_dpp v187, v231, v230 row_ror:8 row_mask:0xf bank_mask:0xf
    v_add_f32_dpp v188, v233, v232 row_ror:8 row_mask:0xf bank_mask:0xf
    v_add_f32_dpp v189, v235, v234 row_ror:8 row_mask:0xf bank_mask:0xf
    v_add_f32_dpp v190, v237, v236 row_ror:8 row_mask:0xf bank_mask:0xf
    v_add_f32_dpp v191, v239, v238 row_ror:8 row_mask:0xf bank_mask:0xf
    s_waitcnt vmcnt(3)
    s_bitcmp1_b32 s67, 0
    s_cbranch_scc0 L_dd30
    s_waitcnt vmcnt(2)
L_dd30:
    buffer_load_dwordx4 v[164:167], v3, s[24:27], s52 offen offset:1024 nt
    s_barrier
    v_mfma_f32_16x16x32_bf16 v[224:227], v[112:115], v[240:243], 0
    v_mfma_f32_16x16x32_bf16 v[228:231], v[120:123], v[240:243], 0
    v_mfma_f32_16x16x32_bf16 v[232:235], v[128:131], v[240:243], 0
    v_mfma_f32_16x16x32_bf16 v[236:239], v[136:139], v[240:243], 0
    v_mfma_f32_16x16x32_bf16 v[224:227], v[116:119], v[244:247], v[224:227]
    v_mfma_f32_16x16x32_bf16 v[228:231], v[124:127], v[244:247], v[228:231]
    v_mfma_f32_16x16x32_bf16 v[232:235], v[132:135], v[244:247], v[232:235]
    v_mfma_f32_16x16x32_bf16 v[236:239], v[140:143], v[244:247], v[236:239]
    v_add_f32_dpp v192, v209, v208 row_ror:8 row_mask:0xf bank_mask:0xf
    v_add_f32_dpp v193, v211, v210 row_ror:8 row_mask:0xf bank_mask:0xf
    v_add_f32_dpp v194, v213, v212 row_ror:8 row_mask:0xf bank_mask:0xf
    v_add_f32_dpp v195, v215, v214 row_ror:8 row_mask:0xf bank_mask:0xf
    v_add_f32_dpp v196, v217, v216 row_ror:8 row_mask:0xf bank_mask:0xf
    v_add_f32_dpp v197, v219, v218 row_ror:8 row_mask:0xf bank_mask:0xf
    v_add_f32_dpp v198, v221, v220 row_ror:8 row_mask:0xf bank_mask:0xf
    v_add_f32_dpp v199, v223, v222 row_ror:8 row_mask:0xf bank_mask:0xf
    v_add_f32_dpp v200, v225, v224 row_ror:8 row_mask:0xf bank_mask:0xf
    v_add_f32_dpp v201, v227, v226 row_ror:8 row_mask:0xf bank_mask:0xf
    v_add_f32_dpp v202, v229, v228 row_ror:8 row_mask:0xf bank_mask:0xf
    v_add_f32_dpp v203, v231, v230 row_ror:8 row_mask:0xf bank_mask:0xf
    v_add_f32_dpp v204, v233, v232 row_ror:8 row_mask:0xf bank_mask:0xf
    v_add_f32_dpp v205, v235, v234 row_ror:8 row_mask:0xf bank_mask:0xf
    v_add_f32_dpp v206, v237, v236 row_ror:8 row_mask:0xf bank_mask:0xf
    v_add_f32_dpp v207, v239, v238 row_ror:8 row_mask:0xf bank_mask:0xf
    v_max3_f32 v248, v176, v177, v178
    v_max3_f32 v249, v179, v180, v181
    v_max3_f32 v248, v248, v182, v183
    v_max3_f32 v249, v249, v184, v185
    v_max3_f32 v248, v248, v186, v187
    v_max3_f32 v249, v249, v188, v189
    v_max3_f32 v248, v248, v190, v191
    s_xor_b32 s52, s52, 0x4a000
    s_waitcnt vmcnt(3)
    s_bitcmp1_b32 s67, 0
    s_cbranch_scc0 L_dd31
    s_waitcnt vmcnt(2)
L_dd31:
    buffer_load_dwordx4 v[168:171], v3, s[24:27], s52 offen offset:0 nt
    s_barrier
    v_max3_f32 v249, v249, v192, v193
    v_max3_f32 v248, v248, v194, v195
    v_max3_f32 v249, v249, v196, v197
    v_max3_f32 v248, v248, v198, v199
    v_max3_f32 v249, v249, v200, v201
    v_max3_f32 v248, v248, v202, v203
    v_max3_f32 v249, v249, v204, v205
    v_max3_f32 v248, v248, v206, v207
    v_max_f32 v248, v248, v249
    v_mov_b32 v249, v248
    s_nop 1
    v_permlane16_swap_b32 v248, v249
    v_max_f32 v248, v248, v249
    v_mov_b32 v249, v248
    s_nop 1
    v_permlane32_swap_b32 v248, v249
    v_max_f32 v248, v248, v249
    s_mov_b32 s72, 0x3e0293ee
    v_mul_f32 v248, s72, v248
    v_mov_b32 v251, 0x7f800000
    s_nop 0
    v_mov_b32_dpp v251, v248 quad_perm:[0,1,2,3] row_mask:0xf bank_mask:0x3
    v_mov_b32_dpp v248, v248 row_ror:8 row_mask:0xf bank_mask:0xc
    v_fma_f32 v176, v176, s72, -v251
    v_fma_f32 v177, v177, s72, -v251
    v_fma_f32 v178, v178, s72, -v251
    v_fma_f32 v179, v179, s72, -v251
    v_fma_f32 v180, v180, s72, -v251
    v_fma_f32 v181, v181, s72, -v251
    v_fma_f32 v182, v182, s72, -v251
    v_fma_f32 v183, v183, s72, -v251
    v_fma_f32 v184, v184, s72, -v251
    s_waitcnt vmcnt(3)
    s_bitcmp1_b32 s67, 0
    s_cbranch_scc0 L_dd32
    s_waitcnt vmcnt(2)
L_dd32:
    buffer_load_dwordx4 v[172:175], v3, s[24:27], s52 offen offset:1024 nt
    s_barrier
    v_fma_f32 v185, v185, s72, -v251
    v_fma_f32 v186, v186, s72, -v251
    v_fma_f32 v187, v187, s72, -v251
    v_fma_f32 v188, v188, s72, -v251
    v_fma_f32 v189, v189, s72, -v251
    v_fma_f32 v190, v190, s72, -v251
    v_fma_f32 v191, v191, s72, -v251
    v_fma_f32 v192, v192, s72, -v251
    v_fma_f32 v193, v193, s72, -v251
    v_fma_f32 v194, v194, s72, -v251
    v_fma_f32 v195, v195, s72, -v251
    v_fma_f32 v196, v196, s72, -v251
    v_fma_f32 v197, v197, s72, -v251
    v_fma_f32 v198, v198, s72, -v251
    v_fma_f32 v199, v199, s72, -v251
    v_fma_f32 v200, v200, s72, -v251
    v_fma_f32 v201, v201, s72, -v251
    v_fma_f32 v202, v202, s72, -v251
    v_fma_f32 v203, v203, s72, -v251
    v_fma_f32 v204, v204, s72, -v251
    v_fma_f32 v205, v205, s72, -v251
    v_fma_f32 v206, v206, s72, -v251
    v_fma_f32 v207, v207, s72, -v251
    v_exp_f32 v176, v176
    v_exp_f32 v177, v177
    v_exp_f32 v178, v178
    v_exp_f32 v179, v179
    v_exp_f32 v180, v180
    v_exp_f32 v181, v181
    v_exp_f32 v182, v182
    v_exp_f32 v183, v183
    s_xor_b32 s52, s52, 0xb8000
    s_waitcnt vmcnt(3)
    s_bitcmp1_b32 s67, 0
    s_cbranch_scc0 L_dd33
    s_waitcnt vmcnt(2)
L_dd33:
    buffer_load_dwordx4 v[16:19], v3, s[24:27], s52 offen offset:0 nt
    s_barrier
    v_exp_f32 v184, v184
    v_exp_f32 v185, v185
    v_exp_f32 v186, v186
    v_exp_f32 v187, v187
    v_exp_f32 v188, v188
    v_exp_f32 v189, v189
    v_exp_f32 v190, v190
    v_exp_f32 v191, v191
    v_exp_f32 v192, v192
    v_exp_f32 v193, v193
    v_exp_f32 v194, v194
    v_exp_f32 v195, v195
    v_exp_f32 v196, v196
    v_exp_f32 v197, v197
    v_exp_f32 v198, v198
    v_exp_f32 v199, v199
    v_exp_f32 v200, v200
    v_exp_f32 v201, v201
    v_exp_f32 v202, v202
    v_exp_f32 v203, v203
    v_exp_f32 v204, v204
    v_exp_f32 v205, v205
    v_exp_f32 v206, v206
    v_exp_f32 v207, v207
    v_add_f32 v249, v176, v177
    v_add_f32 v250, v178, v179
    v_add_f32 v249, v249, v180
    v_add_f32 v250, v250, v181
    v_add_f32 v249, v249, v182
    v_add_f32 v250, v250, v183
    v_add_f32 v249, v249, v184
    v_add_f32 v250, v250, v185
    s_waitcnt vmcnt(3)
    s_bitcmp1_b32 s67, 0
    s_cbranch_scc0 L_dd34
    s_waitcnt vmcnt(2)
L_dd34:
    buffer_load_dwordx4 v[20:23], v3, s[24:27], s52 offen offset:1024 nt
    s_barrier
    v_add_f32 v249, v249, v186
    v_add_f32 v250, v250, v187
    v_add_f32 v249, v249, v188
    v_add_f32 v250, v250, v189
    v_add_f32 v249, v249, v190
    v_add_f32 v250, v250, v191
    v_add_f32 v249, v249, v192
    v_add_f32 v250, v250, v193
    v_add_f32 v249, v249, v194
    v_add_f32 v250, v250, v195
    v_add_f32 v249, v249, v196
    v_add_f32 v250, v250, v197
    v_add_f32 v249, v249, v198
    v_add_f32 v250, v250, v199
    v_add_f32 v249, v249, v200
    v_add_f32 v250, v250, v201
    v_add_f32 v249, v249, v202
    v_add_f32 v250, v250, v203
    v_add_f32 v249, v249, v204
    v_add_f32 v250, v250, v205
    v_add_f32 v249, v249, v206
    v_add_f32 v250, v250, v207
    v_add_f32 v249, v249, v250
    v_mov_b32 v250, v249
    s_nop 1
    v_permlane16_swap_b32 v249, v250
    v_add_f32 v249, v249, v250
    v_mov_b32 v250, v249
    s_nop 1
    v_permlane32_swap_b32 v249, v250
    v_add_f32 v249, v249, v250
    s_lshl_b32 s72, s3, 6
    s_add_u32 s72, s72, 74240
    v_add_u32 v250, s72, v14
    v_add_u32 v251, 74240, v14
    s_mov_b64 exec, 0xff
    ds_write_b64 v250, v[248:249]
    s_mov_b64 exec, 1
    ds_add_rtn_u32 v254, v253, v252 offset:8
    s_mov_b64 exec, -1
    ds_read_b64 v[240:241], v251
    v_cvt_pk_bf16_f32 v112, v176, v177
    v_cvt_pk_bf16_f32 v113, v178, v179
    v_cvt_pk_bf16_f32 v114, v180, v181
    v_cvt_pk_bf16_f32 v115, v182, v183
    v_cvt_pk_bf16_f32 v116, v184, v185
    v_cvt_pk_bf16_f32 v117, v186, v187
    v_cvt_pk_bf16_f32 v118, v188, v189
    v_cvt_pk_bf16_f32 v119, v190, v191
    v_cvt_pk_bf16_f32 v120, v192, v193
    v_cvt_pk_bf16_f32 v121, v194, v195
    v_cvt_pk_bf16_f32 v122, v196, v197
    v_cvt_pk_bf16_f32 v123, v198, v199
    v_mov_b32_dpp v224, v112 row_ror:8 row_mask:0xf bank_mask:0xf
    v_mov_b32_dpp v225, v113 row_ror:8 row_mask:0xf bank_mask:0xf
    v_mov_b32_dpp v226, v114 row_ror:8 row_mask:0xf bank_mask:0xf
    v_mov_b32_dpp v227, v115 row_ror:8 row_mask:0xf bank_mask:0xf
    v_mov_b32_dpp v228, v116 row_ror:8 row_mask:0xf bank_mask:0xf
    v_mov_b32_dpp v229, v117 row_ror:8 row_mask:0xf bank_mask:0xf
    v_mov_b32_dpp v230, v118 row_ror:8 row_mask:0xf bank_mask:0xf
    v_mov_b32_dpp v231, v119 row_ror:8 row_mask:0xf bank_mask:0xf
    v_mov_b32_dpp v232, v120 row_ror:8 row_mask:0xf bank_mask:0xf
    v_mov_b32_dpp v233, v121 row_ror:8 row_mask:0xf bank_mask:0xf
    v_mov_b32_dpp v234, v122 row_ror:8 row_mask:0xf bank_mask:0xf
    v_mov_b32_dpp v235, v123 row_ror:8 row_mask:0xf bank_mask:0xf
    s_waitcnt lgkmcnt(0)
    v_readfirstlane_b32 s72, v254
    s_cmp_lg_u32 s72, 7
    s_cbranch_scc1 L_noml
    v_mov_b32 v242, v240
    s_nop 1
    v_max_f32_dpp v242, v242, v242 row_ror:8 row_mask:0xf bank_mask:0xf
    v_mov_b32 v244, v242
    s_nop 1
    v_permlane16_swap_b32 v242, v244
    v_max_f32 v242, v242, v244
    v_mov_b32 v244, v242
    s_nop 1
    v_permlane32_swap_b32 v242, v244
    v_max_f32 v242, v242, v244
    v_sub_f32 v240, v240, v242
    v_exp_f32 v240, v240
    s_nop 0
    v_mul_f32 v243, v240, v241
    s_nop 1
    v_add_f32_dpp v243, v243, v243 row_ror:8 row_mask:0xf bank_mask:0xf
    v_mov_b32 v244, v243
    s_nop 1
    v_permlane16_swap_b32 v243, v244
    v_add_f32 v243, v243, v244
    v_mov_b32 v244, v243
    s_nop 1
    v_permlane32_swap_b32 v243, v244
    v_add_f32 v243, v243, v244
    s_mov_b64 exec, 0xffff
    buffer_store_dwordx2 v[242:243], v14, s[36:39], s76 offen sc1
    s_mov_b64 exec, -1
L_noml:
    s_xor_b32 s52, s52, 0x4a000
    s_waitcnt vmcnt(3)
    s_bitcmp1_b32 s67, 0
    s_cbranch_scc0 L_dd35
    s_waitcnt vmcnt(2)
L_dd35:
    buffer_load_dwordx4 v[24:27], v3, s[24:27], s52 offen offset:0 nt
    s_barrier
    s_waitcnt vmcnt(3)
    s_bitcmp1_b32 s67, 0
    s_cbranch_scc0 L_dd36
    s_waitcnt vmcnt(2)
L_dd36:
    buffer_load_dwordx4 v[28:31], v3, s[24:27], s52 offen offset:1024 nt
    s_barrier
    v_perm_b32 v128, v148, v144, s60
    v_perm_b32 v129, v156, v152, s60
    v_perm_b32 v130, v164, v160, s60
    v_perm_b32 v131, v172, v168, s60
    v_perm_b32 v132, v150, v146, s60
    v_perm_b32 v133, v158, v154, s60
    v_perm_b32 v134, v166, v162, s60
    v_perm_b32 v135, v174, v170, s60
    v_mfma_f32_16x16x32_bf16 v[208:211], v[128:131], v[112:115], 0
    v_perm_b32 v136, v148, v144, s61
    v_perm_b32 v137, v156, v152, s61
    v_perm_b32 v138, v164, v160, s61
    v_perm_b32 v139, v172, v168, s61
    v_mfma_f32_16x16x32_bf16 v[208:211], v[132:135], v[224:227], v[208:211]
    v_perm_b32 v140, v150, v146, s61
    v_perm_b32 v141, v158, v154, s61
    v_perm_b32 v142, v166, v162, s61
    v_perm_b32 v143, v174, v170, s61
    v_mfma_f32_16x16x32_bf16 v[212:215], v[136:139], v[112:115], 0
    v_perm_b32 v128, v149, v145, s60
    v_perm_b32 v129, v157, v153, s60
    v_perm_b32 v130, v165, v161, s60
    v_perm_b32 v131, v173, v169, s60
    v_mfma_f32_16x16x32_bf16 v[212:215], v[140:143], v[224:227], v[212:215]
    v_perm_b32 v132, v151, v147, s60
    v_perm_b32 v133, v159, v155, s60
    v_perm_b32 v134, v167, v163, s60
    v_perm_b32 v135, v175, v171, s60
    v_mfma_f32_16x16x32_bf16 v[216:219], v[128:131], v[112:115], 0
    v_perm_b32 v136, v149, v145, s61
    v_perm_b32 v137, v157, v153, s61
    v_perm_b32 v138, v165, v161, s61
    v_perm_b32 v139, v173, v169, s61
    v_mfma_f32_16x16x32_bf16 v[216:219], v[132:135], v[224:227], v[216:219]
    v_perm_b32 v140, v151, v147, s61
    v_perm_b32 v141, v159, v155, s61
    v_perm_b32 v142, v167, v163, s61
    v_perm_b32 v143, v175, v171, s61
    v_mfma_f32_16x16x32_bf16 v[220:223], v[136:139], v[112:115], 0
    s_nop 1
    v_mfma_f32_16x16x32_bf16 v[220:223], v[140:143], v[224:227], v[220:223]
    s_xor_b32 s52, s52, 0xbc000
    s_waitcnt vmcnt(3)
    s_bitcmp1_b32 s67, 0
    s_cbranch_scc0 L_dd37
    s_waitcnt vmcnt(2)
L_dd37:
    buffer_load_dwordx4 v[32:35], v3, s[24:27], s52 offen offset:0 nt
    s_barrier
    v_lshrrev_b32 v7, 1, v5
    v_xor_b32 v7, v7, v6
    v_lshlrev_b32 v7, 5, v7
    v_lshl_add_u32 v7, v6, 14, v7
    v_and_b32 v4, 1, v5
    v_lshl_add_u32 v7, v4, 4, v7
    v_xor_b32 v4, 128, v7
    s_mul_i32 s72, s3, 4352
    v_and_b32 v9, 7, v5
    v_mul_u32_u24 v9, 528, v9
    v_lshl_add_u32 v9, v6, 4, v9
    v_and_b32 v10, 8, v5
    v_lshl_add_u32 v9, v10, 5, v9
    v_add_u32 v9, s72, v9
    s_mul_i32 s72, s3, 528
    v_add_u32 v10, s72, v14
    v_lshrrev_b32 v8, 2, v5
    v_and_b32 v11, 1, v6
    v_lshl_add_u32 v11, v11, 2, v8
    v_xor_b32 v11, s3, v11
    v_lshl_add_u32 v8, v6, 3, v8
    v_lshlrev_b32 v8, 8, v8
    v_lshl_add_u32 v8, v11, 5, v8
    v_and_b32 v11, 3, v5
    v_lshl_add_u32 v8, v11, 3, v8
    s_mul_i32 s72, s3, 544
    s_add_u32 s72, s72, 69888
    v_lshrrev_b32 v11, 1, v6
    v_mul_u32_u24 v11, 272, v11
    v_lshl_add_u32 v11, v5, 4, v11
    v_and_b32 v15, 1, v6
    v_lshl_add_u32 v11, v15, 3, v11
    v_add_u32 v11, s72, v11
    v_mul_u32_u24 v15, 272, v5
    v_lshl_add_u32 v15, v6, 4, v15
    v_add_u32 v15, 69888, v15
    v_and_b32 v250, 1, v5
    v_lshlrev_b32 v250, 4, v250
    s_waitcnt vmcnt(3)
    s_bitcmp1_b32 s67, 0
    s_cbranch_scc0 L_dd38
    s_waitcnt vmcnt(2)
L_dd38:
    buffer_load_dwordx4 v[36:39], v3, s[24:27], s52 offen offset:1024 nt
    s_barrier
    v_mov_b32 v251, 0x3f80
    v_lshlrev_b32 v250, v250, v251
    v_lshrrev_b32 v254, 1, v5
    v_lshlrev_b32 v254, v254, v252
    v_bfe_i32 v160, v254, 0, 1
    v_and_b32 v160, v160, v250
    v_bfe_i32 v161, v254, 1, 1
    v_and_b32 v161, v161, v250
    v_bfe_i32 v162, v254, 2, 1
    v_and_b32 v162, v162, v250
    v_bfe_i32 v163, v254, 3, 1
    v_and_b32 v163, v163, v250
    v_bfe_i32 v164, v254, 4, 1
    v_and_b32 v164, v164, v250
    v_bfe_i32 v165, v254, 5, 1
    v_and_b32 v165, v165, v250
    v_bfe_i32 v166, v254, 6, 1
    v_and_b32 v166, v166, v250
    v_bfe_i32 v167, v254, 7, 1
    v_and_b32 v167, v167, v250
    v_and_b32 v254, 3, v5
    v_lshrrev_b32 v250, 2, v5
    v_lshl_add_u32 v254, v254, 2, v250
    v_and_b32 v250, 1, v254
    v_lshlrev_b32 v250, 4, v250
    v_lshlrev_b32 v250, v250, v251
    v_lshrrev_b32 v254, 1, v254
    v_lshlrev_b32 v254, v254, v252
    v_bfe_i32 v168, v254, 0, 1
    v_and_b32 v168, v168, v250
    v_bfe_i32 v169, v254, 1, 1
    v_and_b32 v169, v169, v250
    v_bfe_i32 v170, v254, 2, 1
    v_and_b32 v170, v170, v250
    v_bfe_i32 v171, v254, 3, 1
    v_and_b32 v171, v171, v250
    v_lshlrev_b32 v2, 11, v6
    v_lshl_add_u32 v2, v5, 2, v2
    s_lshl_b32 s66, s64, 7
    s_add_u32 s66, s66, s3
    s_lshl_b32 s66, s66, 3
    s_add_u32 s66, s66, s65
    s_lshl_b32 s66, s66, 8
    s_lshr_b32 s72, s66, 7
    s_xor_b32 s72, s72, s66
    s_bitcmp1_b32 s72, 13
    s_cselect_b32 s72, 0x102000, 0
    s_xor_b32 s66, s66, s72
    s_lshr_b32 s72, s64, 3
    s_lshr_b32 s72, s58, s72
    s_and_b32 s72, s72, 1
    s_lshl_b32 s72, s72, 13
    s_xor_b32 s66, s66, s72
    s_lshr_b32 s72, s74, 6
    s_xor_b32 s72, s72, s74
    s_bitcmp1_b32 s72, 7
    s_cselect_b32 s72, 0x2080, 0
    s_xor_b32 s74, s74, s72
    s_and_b32 s72, s62, 3
    s_lshr_b32 s72, s58, s72
    s_and_b32 s72, s72, 1
    v_lshrrev_b32 v250, 5, v1
    v_xor_b32 v250, s72, v250
    v_and_b32 v12, 31, v1
    v_lshlrev_b32 v12, 2, v12
    v_lshl_add_u32 v12, v250, 13, v12
    s_xor_b32 s52, s52, 0x4a000
    s_waitcnt vmcnt(3)
    s_bitcmp1_b32 s67, 0
    s_cbranch_scc0 L_dd39
    s_waitcnt vmcnt(2)
L_dd39:
    buffer_load_dwordx4 v[40:43], v3, s[24:27], s52 offen offset:0 nt
    s_barrier
    s_and_b32 s79, s64, 1
    s_lshl_b32 s79, s79, 14
    s_bfe_u32 s72, s64, 0x20001
    s_lshl_b32 s72, s72, 12
    s_or_b32 s79, s79, s72
    s_lshr_b32 s72, s64, 3
    s_lshl_b32 s72, s72, 17
    s_or_b32 s79, s79, s72
    s_and_b32 s72, s3, 1
    s_lshl_b32 s72, s72, 11
    s_or_b32 s79, s79, s72
    s_lshr_b32 s72, s3, 1
    s_lshl_b32 s72, s72, 15
    s_or_b32 s79, s79, s72
    s_xor_b32 s79, s79, 0x101000
    s_mov_b32 s69, 0x0
    s_bitcmp1_b32 s64, 0
    s_cselect_b32 s72, 0x4000, 0
    s_xor_b32 s69, s69, s72
    s_bitcmp1_b32 s65, 2
    s_cselect_b32 s72, 0x4000, 0
    s_xor_b32 s69, s69, s72
    s_bfe_u32 s72, s64, 0x20001
    s_lshl_b32 s72, s72, 12
    s_or_b32 s69, s69, s72
    s_lshr_b32 s71, s2, 3
    s_lshl_b32 s72, s71, 15
    s_or_b32 s69, s69, s72
    s_waitcnt vmcnt(3)
    s_bitcmp1_b32 s67, 0
    s_cbranch_scc0 L_dd40
    s_waitcnt vmcnt(2)
L_dd40:
    buffer_load_dwordx4 v[44:47], v3, s[24:27], s52 offen offset:1024 nt
    s_barrier
    s_mov_b32 s71, 0x0
    s_bitcmp1_b32 s64, 0
    s_cselect_b32 s72, 0x2, 0
    s_xor_b32 s71, s71, s72
    s_bitcmp1_b32 s64, 1
    s_cselect_b32 s72, 0x10, 0
    s_xor_b32 s71, s71, s72
    s_bitcmp1_b32 s64, 2
    s_cselect_b32 s72, 0x1, 0
    s_xor_b32 s71, s71, s72
    s_and_b32 s72, s2, 0xe0
    s_or_b32 s71, s71, s72
    s_lshr_b32 s72, s64, 3
    s_lshl_b32 s72, s72, 2
    s_or_b32 s71, s71, s72
    s_and_b32 s70, s71, 3
    s_lshl_b32 s70, s70, 13
    s_lshr_b32 s71, s71, 2
    s_lshl_b32 s71, s71, 5
    s_add_u32 s70, s70, s71
    s_mov_b32 s67, 0
    s_xor_b32 s52, s52, 0xe4800
    s_waitcnt vmcnt(3)
    s_bitcmp1_b32 s67, 0
    s_cbranch_scc0 L_dd41
    s_waitcnt vmcnt(2)
L_dd41:
    buffer_load_dwordx4 v[48:51], v3, s[24:27], s52 offen offset:0 nt
    s_barrier
    s_waitcnt vmcnt(3)
    s_bitcmp1_b32 s67, 0
    s_cbranch_scc0 L_dd42
    s_waitcnt vmcnt(2)
L_dd42:
    buffer_load_dwordx4 v[52:55], v3, s[24:27], s52 offen offset:1024 nt
    s_barrier
    s_xor_b32 s52, s52, 0x4a000
    s_waitcnt vmcnt(3)
    s_bitcmp1_b32 s67, 0
    s_cbranch_scc0 L_dd43
    s_waitcnt vmcnt(2)
L_dd43:
    buffer_load_dwordx4 v[56:59], v3, s[24:27], s52 offen offset:0 nt
    s_barrier
    s_waitcnt vmcnt(3)
    s_bitcmp1_b32 s67, 0
    s_cbranch_scc0 L_dd44
    s_waitcnt vmcnt(2)
L_dd44:
    buffer_load_dwordx4 v[60:63], v3, s[24:27], s52 offen offset:1024 nt
    s_barrier
    v_perm_b32 v128, v20, v16, s60
    v_perm_b32 v129, v28, v24, s60
    v_perm_b32 v130, v36, v32, s60
    v_perm_b32 v131, v44, v40, s60
    v_perm_b32 v132, v22, v18, s60
    v_perm_b32 v133, v30, v26, s60
    v_perm_b32 v134, v38, v34, s60
    v_perm_b32 v135, v46, v42, s60
    v_mfma_f32_16x16x32_bf16 v[208:211], v[128:131], v[116:119], v[208:211]
    v_perm_b32 v136, v20, v16, s61
    v_perm_b32 v137, v28, v24, s61
    v_perm_b32 v138, v36, v32, s61
    v_perm_b32 v139, v44, v40, s61
    v_mfma_f32_16x16x32_bf16 v[208:211], v[132:135], v[228:231], v[208:211]
    v_perm_b32 v140, v22, v18, s61
    v_perm_b32 v141, v30, v26, s61
    v_perm_b32 v142, v38, v34, s61
    v_perm_b32 v143, v46, v42, s61
    v_mfma_f32_16x16x32_bf16 v[212:215], v[136:139], v[116:119], v[212:215]
    v_perm_b32 v128, v21, v17, s60
    v_perm_b32 v129, v29, v25, s60
    v_perm_b32 v130, v37, v33, s60
    v_perm_b32 v131, v45, v41, s60
    v_mfma_f32_16x16x32_bf16 v[212:215], v[140:143], v[228:231], v[212:215]
    v_perm_b32 v132, v23, v19, s60
    v_perm_b32 v133, v31, v27, s60
    v_perm_b32 v134, v39, v35, s60
    v_perm_b32 v135, v47, v43, s60
    v_mfma_f32_16x16x32_bf16 v[216:219], v[128:131], v[116:119], v[216:219]
    v_perm_b32 v136, v21, v17, s61
    v_perm_b32 v137, v29, v25, s61
    v_perm_b32 v138, v37, v33, s61
    v_perm_b32 v139, v45, v41, s61
    v_mfma_f32_16x16x32_bf16 v[216:219], v[132:135], v[228:231], v[216:219]
    v_perm_b32 v140, v23, v19, s61
    v_perm_b32 v141, v31, v27, s61
    v_perm_b32 v142, v39, v35, s61
    v_perm_b32 v143, v47, v43, s61
    v_mfma_f32_16x16x32_bf16 v[220:223], v[136:139], v[116:119], v[220:223]
    s_nop 1
    v_mfma_f32_16x16x32_bf16 v[220:223], v[140:143], v[228:231], v[220:223]
    s_xor_b32 s52, s52, 0xbc000
    s_waitcnt vmcnt(3)
    s_bitcmp1_b32 s67, 0
    s_cbranch_scc0 L_dd45
    s_waitcnt vmcnt(2)
L_dd45:
    buffer_load_dwordx4 v[64:67], v3, s[24:27], s52 offen offset:0 nt
    s_barrier
    s_waitcnt vmcnt(3)
    s_bitcmp1_b32 s67, 0
    s_cbranch_scc0 L_dd46
    s_waitcnt vmcnt(2)
L_dd46:
    buffer_load_dwordx4 v[68:71], v3, s[24:27], s52 offen offset:1024 nt
    s_barrier
    s_xor_b32 s52, s52, 0x4a000
    s_waitcnt vmcnt(3)
    s_bitcmp1_b32 s67, 0
    s_cbranch_scc0 L_dd47
    s_waitcnt vmcnt(2)
L_dd47:
    buffer_load_dwordx4 v[72:75], v3, s[24:27], s52 offen offset:0 nt
    s_barrier
    s_waitcnt vmcnt(3)
    s_bitcmp1_b32 s67, 0
    s_cbranch_scc0 L_dd48
    s_waitcnt vmcnt(2)
L_dd48:
    buffer_load_dwordx4 v[76:79], v3, s[24:27], s52 offen offset:1024 nt
    s_barrier
    s_xor_b32 s52, s52, 0xb8000
    s_waitcnt vmcnt(3)
    s_bitcmp1_b32 s67, 0
    s_cbranch_scc0 L_dd49
    s_waitcnt vmcnt(2)
L_dd49:
    buffer_load_dwordx4 v[80:83], v3, s[24:27], s52 offen offset:0 nt
    s_barrier
    s_waitcnt vmcnt(3)
    s_bitcmp1_b32 s67, 0
    s_cbranch_scc0 L_dd50
    s_waitcnt vmcnt(2)
L_dd50:
    buffer_load_dwordx4 v[84:87], v3, s[24:27], s52 offen offset:1024 nt
    s_barrier
    s_xor_b32 s52, s52, 0x4a000
    s_waitcnt vmcnt(3)
    s_bitcmp1_b32 s67, 0
    s_cbranch_scc0 L_dd51
    s_waitcnt vmcnt(2)
L_dd51:
    buffer_load_dwordx4 v[88:91], v3, s[24:27], s52 offen offset:0 nt
    s_barrier
    s_waitcnt vmcnt(3)
    s_bitcmp1_b32 s67, 0
    s_cbranch_scc0 L_dd52
    s_waitcnt vmcnt(2)
L_dd52:
    buffer_load_dwordx4 v[92:95], v3, s[24:27], s52 offen offset:1024 nt
    s_barrier
    buffer_load_dwordx2 v[176:177], v14, s[36:39], s77 offen sc1
    v_perm_b32 v128, v52, v48, s60
    v_perm_b32 v129, v60, v56, s60
    v_perm_b32 v130, v68, v64, s60
    v_perm_b32 v131, v76, v72, s60
    v_perm_b32 v132, v54, v50, s60
    v_perm_b32 v133, v62, v58, s60
    v_perm_b32 v134, v70, v66, s60
    v_perm_b32 v135, v78, v74, s60
    v_mfma_f32_16x16x32_bf16 v[208:211], v[128:131], v[120:123], v[208:211]
    v_perm_b32 v136, v52, v48, s61
    v_perm_b32 v137, v60, v56, s61
    v_perm_b32 v138, v68, v64, s61
    v_perm_b32 v139, v76, v72, s61
    v_mfma_f32_16x16x32_bf16 v[208:211], v[132:135], v[232:235], v[208:211]
    v_perm_b32 v140, v54, v50, s61
    v_perm_b32 v141, v62, v58, s61
    v_perm_b32 v142, v70, v66, s61
    v_perm_b32 v143, v78, v74, s61
    v_mfma_f32_16x16x32_bf16 v[212:215], v[136:139], v[120:123], v[212:215]
    v_perm_b32 v128, v53, v49, s60
    v_perm_b32 v129, v61, v57, s60
    v_perm_b32 v130, v69, v65, s60
    v_perm_b32 v131, v77, v73, s60
    v_mfma_f32_16x16x32_bf16 v[212:215], v[140:143], v[232:235], v[212:215]
    v_perm_b32 v132, v55, v51, s60
    v_perm_b32 v133, v63, v59, s60
    v_perm_b32 v134, v71, v67, s60
    v_perm_b32 v135, v79, v75, s60
    v_mfma_f32_16x16x32_bf16 v[216:219], v[128:131], v[120:123], v[216:219]
    v_perm_b32 v136, v53, v49, s61
    v_perm_b32 v137, v61, v57, s61
    v_perm_b32 v138, v69, v65, s61
    v_perm_b32 v139, v77, v73, s61
    v_mfma_f32_16x16x32_bf16 v[216:219], v[132:135], v[232:235], v[216:219]
    v_perm_b32 v140, v55, v51, s61
    v_perm_b32 v141, v63, v59, s61
    v_perm_b32 v142, v71, v67, s61
    v_perm_b32 v143, v79, v75, s61
    v_mfma_f32_16x16x32_bf16 v[220:223], v[136:139], v[120:123], v[220:223]
    s_nop 1
    v_mfma_f32_16x16x32_bf16 v[220:223], v[140:143], v[232:235], v[220:223]
    s_xor_b32 s52, s52, 0xbc000
    s_waitcnt vmcnt(4)
    s_bitcmp1_b32 s67, 0
    s_cbranch_scc0 L_dd53
    s_waitcnt vmcnt(3)
L_dd53:
    buffer_load_dwordx4 v[96:99], v3, s[24:27], s52 offen offset:0 nt
    s_barrier
    s_waitcnt vmcnt(4)
    s_bitcmp1_b32 s67, 0
    s_cbranch_scc0 L_dd54
    s_waitcnt vmcnt(3)
L_dd54:
    buffer_load_dwordx4 v[100:103], v3, s[24:27], s52 offen offset:1024 nt
    s_barrier
    s_xor_b32 s52, s52, 0x4a000
    s_waitcnt vmcnt(4)
    s_bitcmp1_b32 s67, 0
    s_cbranch_scc0 L_dd55
    s_waitcnt vmcnt(3)
L_dd55:
    buffer_load_dwordx4 v[104:107], v3, s[24:27], s52 offen offset:0 nt
    s_barrier
    s_waitcnt vmcnt(4)
    s_bitcmp1_b32 s67, 0
    s_cbranch_scc0 L_dd56
    s_waitcnt vmcnt(3)
L_dd56:
    buffer_load_dwordx4 v[108:111], v3, s[24:27], s52 offen offset:1024 nt
    s_barrier
    s_waitcnt vmcnt(4)
    s_mov_b32 s72, 0
L_poll1:
    v_max_u32 v250, v176, v177
    v_cmp_eq_u32 vcc, -1, v250
    s_cbranch_vccz L_poll1_done
    s_add_u32 s72, s72, 1
    s_cmp_gt_u32 s72, 400000
    s_cbranch_scc1 L_poll1_done
    s_sleep 2
    buffer_load_dwordx2 v[176:177], v14, s[36:39], s77 offen sc1
    s_waitcnt vmcnt(0)
    s_branch L_poll1
L_poll1_done:
    v_mov_b32 v250, v176
    v_mov_b32 v251, v250
    s_nop 1
    v_permlane16_swap_b32 v250, v251
    v_max_f32 v250, v250, v251
    v_mov_b32 v251, v250
    s_nop 1
    v_permlane32_swap_b32 v250, v251
    v_max_f32 v250, v250, v251
    v_sub_f32 v176, v176, v250
    v_sub_f32 v248, v248, v250
    v_exp_f32 v176, v176
    v_exp_f32 v248, v248
    v_mul_f32 v251, v176, v177
    v_mov_b32 v250, v251
    s_nop 1
    v_permlane16_swap_b32 v251, v250
    v_add_f32 v251, v251, v250
    v_mov_b32 v250, v251
    s_nop 1
    v_permlane32_swap_b32 v251, v250
    v_add_f32 v251, v251, v250
    v_rcp_f32 v251, v251
    s_nop 0
    v_mul_f32 v248, v248, v251
    v_mul_f32 v200, v248, v200
    v_mul_f32 v201, v248, v201
    v_mul_f32 v202, v248, v202
    v_mul_f32 v203, v248, v203
    v_mul_f32 v204, v248, v204
    v_mul_f32 v205, v248, v205
    v_mul_f32 v206, v248, v206
    v_mul_f32 v207, v248, v207
    v_cvt_pk_bf16_f32 v124, v200, v201
    v_cvt_pk_bf16_f32 v125, v202, v203
    v_cvt_pk_bf16_f32 v126, v204, v205
    v_cvt_pk_bf16_f32 v127, v206, v207
    v_mov_b32_dpp v236, v124 row_ror:8 row_mask:0xf bank_mask:0xf
    v_mov_b32_dpp v237, v125 row_ror:8 row_mask:0xf bank_mask:0xf
    v_mov_b32_dpp v238, v126 row_ror:8 row_mask:0xf bank_mask:0xf
    v_mov_b32_dpp v239, v127 row_ror:8 row_mask:0xf bank_mask:0xf
    v_mul_f32 v208, v248, v208
    v_mul_f32 v209, v248, v209
    v_mul_f32 v210, v248, v210
    v_mul_f32 v211, v248, v211
    v_mul_f32 v212, v248, v212
    v_mul_f32 v213, v248, v213
    v_mul_f32 v214, v248, v214
    v_mul_f32 v215, v248, v215
    v_mul_f32 v216, v248, v216
    v_mul_f32 v217, v248, v217
    v_mul_f32 v218, v248, v218
    v_mul_f32 v219, v248, v219
    v_mul_f32 v220, v248, v220
    v_mul_f32 v221, v248, v221
    v_mul_f32 v222, v248, v222
    v_mul_f32 v223, v248, v223
    v_perm_b32 v16, v84, v80, s60
    v_perm_b32 v20, v84, v80, s61
    v_perm_b32 v24, v85, v81, s60
    v_perm_b32 v28, v85, v81, s61
    v_perm_b32 v32, v86, v82, s60
    v_perm_b32 v36, v86, v82, s61
    v_perm_b32 v40, v87, v83, s60
    v_perm_b32 v44, v87, v83, s61
    v_perm_b32 v17, v92, v88, s60
    v_perm_b32 v21, v92, v88, s61
    v_perm_b32 v25, v93, v89, s60
    v_perm_b32 v29, v93, v89, s61
    v_perm_b32 v33, v94, v90, s60
    v_perm_b32 v37, v94, v90, s61
    v_perm_b32 v41, v95, v91, s60
    v_perm_b32 v45, v95, v91, s61
    s_waitcnt vmcnt(2)
    v_perm_b32 v18, v100, v96, s60
    v_perm_b32 v22, v100, v96, s61
    v_perm_b32 v26, v101, v97, s60
    v_perm_b32 v30, v101, v97, s61
    v_perm_b32 v34, v102, v98, s60
    v_perm_b32 v38, v102, v98, s61
    v_perm_b32 v42, v103, v99, s60
    v_perm_b32 v46, v103, v99, s61
    s_waitcnt vmcnt(0)
    s_add_u32 m0, s73, 37120
    s_add_u32 s71, s66, 0
    buffer_load_dwordx4 v7, s[32:35], s71 offen nt lds
    s_add_u32 m0, s73, 38144
    s_add_u32 s71, s66, 65536
    buffer_load_dwordx4 v7, s[32:35], s71 offen nt lds
    s_add_u32 m0, s73, 39168
    s_add_u32 s71, s66, 131072
    buffer_load_dwordx4 v4, s[32:35], s71 offen nt lds
    s_add_u32 m0, s73, 40192
    s_add_u32 s71, s66, 196608
    buffer_load_dwordx4 v4, s[32:35], s71 offen nt lds
    v_perm_b32 v19, v108, v104, s60
    v_perm_b32 v35, v110, v106, s60
    v_perm_b32 v23, v108, v104, s61
    v_mfma_f32_16x16x32_bf16 v[208:211], v[16:19], v[124:127], v[208:211]
    v_perm_b32 v39, v110, v106, s61
    v_mfma_f32_16x16x32_bf16 v[208:211], v[32:35], v[236:239], v[208:211]
    v_perm_b32 v27, v109, v105, s60
    v_mfma_f32_16x16x32_bf16 v[212:215], v[20:23], v[124:127], v[212:215]
    v_perm_b32 v43, v111, v107, s60
    v_mfma_f32_16x16x32_bf16 v[212:215], v[36:39], v[236:239], v[212:215]
    v_perm_b32 v31, v109, v105, s61
    v_mfma_f32_16x16x32_bf16 v[216:219], v[24:27], v[124:127], v[216:219]
    v_perm_b32 v47, v111, v107, s61
    v_mfma_f32_16x16x32_bf16 v[216:219], v[40:43], v[236:239], v[216:219]
    v_mfma_f32_16x16x32_bf16 v[220:223], v[28:31], v[124:127], v[220:223]
    v_mfma_f32_16x16x32_bf16 v[220:223], v[44:47], v[236:239], v[220:223]
    ds_write_b128 v9, v[208:211] offset:0
    s_nop 0
    ds_write_b128 v9, v[212:215] offset:64
    s_nop 2
    ds_write_b128 v9, v[216:219] offset:128
    s_nop 0
    ds_write_b128 v9, v[220:223] offset:192
    s_waitcnt lgkmcnt(0)
    s_barrier
    ds_read_b64 v[176:177], v10 offset:0
    ds_read_b64 v[178:179], v10 offset:4352
    ds_read_b64 v[180:181], v10 offset:8704
    ds_read_b64 v[182:183], v10 offset:13056
    ds_read_b64 v[184:185], v10 offset:17408
    ds_read_b64 v[186:187], v10 offset:21760
    ds_read_b64 v[188:189], v10 offset:26112
    ds_read_b64 v[190:191], v10 offset:30464
    s_waitcnt lgkmcnt(4)
    v_pk_add_f32 v[176:177], v[176:177], v[178:179]
    v_pk_add_f32 v[180:181], v[180:181], v[182:183]
    v_pk_add_f32 v[176:177], v[176:177], v[180:181]
    s_waitcnt lgkmcnt(2)
    v_pk_add_f32 v[184:185], v[184:185], v[186:187]
    v_pk_add_f32 v[176:177], v[176:177], v[184:185]
    s_waitcnt lgkmcnt(0)
    v_pk_add_f32 v[188:189], v[188:189], v[190:191]
    v_pk_add_f32 v[176:177], v[176:177], v[188:189]
    v_cvt_pk_bf16_f32 v176, v176, v177
    buffer_store_dword v176, v12, s[36:39], s74 offen sc1
    s_waitcnt vmcnt(1)
    s_barrier
    buffer_load_dwordx4 v[48:51], v3, s[36:39], s79 offen offset:0 sc1
    buffer_load_dwordx4 v[52:55], v3, s[36:39], s79 offen offset:1024 sc1
    ds_read_b64_tr_b16 v[144:145], v8 offset:37120
    ds_read_b64_tr_b16 v[146:147], v8 offset:38144
    ds_read_b64_tr_b16 v[148:149], v8 offset:45312
    ds_read_b64_tr_b16 v[150:151], v8 offset:46336
    ds_read_b64_tr_b16 v[152:153], v8 offset:53504
    ds_read_b64_tr_b16 v[154:155], v8 offset:54528
    ds_read_b64_tr_b16 v[156:157], v8 offset:61696
    ds_read_b64_tr_b16 v[158:159], v8 offset:62720
    s_mov_b32 s72, 0
    s_branch L_poll2_chk
L_poll2:
    buffer_load_dwordx4 v[48:51], v3, s[36:39], s79 offen offset:0 sc1
    buffer_load_dwordx4 v[52:55], v3, s[36:39], s79 offen offset:1024 sc1
L_poll2_chk:
    s_waitcnt vmcnt(1)
    v_mfma_f32_16x16x32_bf16 v[208:211], v[160:163], v[48:51], 0
    s_waitcnt vmcnt(0)
    v_mfma_f32_16x16x32_bf16 v[208:211], v[164:167], v[52:55], v[208:211]
    v_max3_u32 v250, v48, v49, v50
    v_max3_u32 v251, v51, v52, v53
    v_max3_u32 v250, v250, v54, v55
    v_max_u32 v250, v250, v251
    v_cmp_eq_u32 vcc, -1, v250
    s_cbranch_vccz L_poll2_done
    s_add_u32 s72, s72, 1
    s_cmp_gt_u32 s72, 400000
    s_cbranch_scc0 L_poll2
L_poll2_done:
    s_nop 1
    v_cvt_pk_bf16_f32 v208, v208, v209
    v_cvt_pk_bf16_f32 v209, v210, v211
    ds_write_b64 v11, v[208:209]
    s_waitcnt lgkmcnt(0)
    s_barrier
    ds_read_b128 v[176:179], v15 offset:0
    ds_read_b128 v[180:183], v15 offset:64
    ds_read_b128 v[184:187], v15 offset:128
    ds_read_b128 v[188:191], v15 offset:192
    s_waitcnt lgkmcnt(3)
    v_mfma_f32_16x16x32_bf16 v[212:215], v[176:179], v[144:147], 0
    s_waitcnt lgkmcnt(2)
    v_mfma_f32_16x16x32_bf16 v[212:215], v[180:183], v[148:151], v[212:215]
    s_waitcnt lgkmcnt(1)
    v_mfma_f32_16x16x32_bf16 v[212:215], v[184:187], v[152:155], v[212:215]
    s_waitcnt lgkmcnt(0)
    v_mfma_f32_16x16x32_bf16 v[212:215], v[188:191], v[156:159], v[212:215]
    s_cmp_lg_u32 s3, 7
    s_mov_b32 s72, 0
    s_nop 5
    v_cvt_pk_bf16_f32 v212, v212, v213
    v_cvt_pk_bf16_f32 v213, v214, v215
    buffer_store_dwordx2 v[212:213], v13, s[36:39], s75 offen sc1
    s_cbranch_scc1 L_end
    s_waitcnt vmcnt(0)
L_poll3:
    buffer_load_dwordx4 v[16:19], v3, s[36:39], s69 offen offset:0 sc1
    buffer_load_dwordx4 v[20:23], v3, s[36:39], s69 offen offset:1024 sc1
    buffer_load_dwordx4 v[24:27], v3, s[36:39], s69 offen offset:2048 sc1
    buffer_load_dwordx4 v[28:31], v3, s[36:39], s69 offen offset:3072 sc1
    s_waitcnt vmcnt(3)
    v_mfma_f32_16x16x32_bf16 v[208:211], v[168:171], v[16:19], 0
    s_waitcnt vmcnt(2)
    v_mfma_f32_16x16x32_bf16 v[208:211], v[168:171], v[20:23], v[208:211]
    s_waitcnt vmcnt(1)
    v_mfma_f32_16x16x32_bf16 v[208:211], v[168:171], v[24:27], v[208:211]
    s_waitcnt vmcnt(0)
    v_mfma_f32_16x16x32_bf16 v[208:211], v[168:171], v[28:31], v[208:211]
    v_max3_u32 v250, v16, v17, v18
    v_max3_u32 v251, v19, v20, v21
    v_max3_u32 v250, v250, v22, v23
    v_max3_u32 v251, v251, v24, v25
    v_max3_u32 v250, v250, v26, v27
    v_max3_u32 v251, v251, v28, v29
    v_max3_u32 v250, v250, v30, v31
    v_max_u32 v250, v250, v251
    v_cmp_eq_u32 vcc, -1, v250
    s_cbranch_vccz L_poll3_done
    s_add_u32 s72, s72, 1
    s_cmp_gt_u32 s72, 400000
    s_cbranch_scc0 L_poll3
L_poll3_done:
    v_add_f32_dpp v208, v208, v208 row_ror:8 row_mask:0xf bank_mask:0xf
    v_add_f32_dpp v209, v209, v209 row_ror:8 row_mask:0xf bank_mask:0xf
    s_mov_b32 exec_lo, 0x00ff00ff
    s_mov_b32 exec_hi, 0x00ff00ff
    v_cvt_pk_bf16_f32 v208, v208, v209
    buffer_store_dword v208, v2, s[44:47], s70 offen
L_end:
    s_endpgm
.section .rodata,"a"
.p2align 6
.amdhsa_kernel standalone__gqa_block_cached__sampling_kernel
  .amdhsa_next_free_vgpr 256
  .amdhsa_next_free_sgpr 80
  .amdhsa_accum_offset 256
  .amdhsa_group_segment_fixed_size 0
  .amdhsa_kernarg_size 64
  .amdhsa_user_sgpr_count 2
  .amdhsa_user_sgpr_kernarg_segment_ptr 1
  .amdhsa_system_sgpr_workgroup_id_x 1
  .amdhsa_float_denorm_mode_32 3
.end_amdhsa_kernel
```
